```python
import torch

def _softmax(x, axis=-1):
    return torch.softmax(x, dim=axis)
def _gelu(x):
    return torch.nn.functional.gelu(x, approximate="tanh")
def _silu(x):
    return torch.nn.functional.silu(x)
def _sigmoid(x):
    return torch.sigmoid(x)
def _layernorm(x, axis=-1, eps=1e-5):
    m = x.mean(dim=axis, keepdim=True)
    v = x.var(dim=axis, keepdim=True, unbiased=False)
    return (x - m) / torch.sqrt(v + eps)
def _scatter_add(tgt, idx, src, axis=0):
    return tgt.clone().index_add_(axis, idx, src)
def _segment_sum(src, seg, n):
    out = torch.zeros((n,) + src.shape[1:], dtype=src.dtype)
    return out.index_add_(0, seg, src)
def _pad(x, pw):
    flat = tuple(v for pair in reversed(pw) for v in pair)
    return torch.nn.functional.pad(x, flat)

kernel_name = 'recurrent_scan__sliding_block_cached__mixer_token_mlp__decode'

def setup_inputs():

    _w = (lambda a: (lambda t: t.to(torch.bfloat16) if t.is_floating_point() else t)(torch.as_tensor(a)))
    def _A_setup():
        B, Sq, D = 4, 1, 512
        Hq, Hkv, Sk, Dh = 32, 8, 4096, 128
        assert Hq % Hkv == 0, (Hq, Hkv)
        return {
            "x": _w((lambda *s: torch.randn(*s, dtype=torch.bfloat16) * 0.05)(B, Sq, D)),
            "k_cache": _w((lambda *s: torch.randn(*s, dtype=torch.bfloat16) * 3.2)(B, Hkv, Sk, Dh)),
            "v_cache": _w((lambda *s: torch.randn(*s, dtype=torch.bfloat16) * 3.2)(B, Hkv, Sk, Dh)),
            "wq": _w((lambda *s: torch.randn(*s, dtype=torch.bfloat16) * 3.2)(D, Hq * Dh) * (D ** -0.5)),
            "wo": _w((lambda *s: torch.randn(*s, dtype=torch.bfloat16) * 3.2)(Hq * Dh, D) * ((Hq * Dh) ** -0.5)),
        }
    _A_in = _A_setup()

    def _B_setup():
        B, S, D, F = 4, 1, 512, 1792
        return {
            "x": _w((lambda *s: torch.randn(*s, dtype=torch.bfloat16) * 0.05)(B, S, D)),
            "w1": _w((lambda *s: torch.randn(*s, dtype=torch.bfloat16) * 3.2)(S, F) * (S ** -0.5)),
            "b1": _w((lambda *s: torch.randn(*s, dtype=torch.bfloat16) * 3.2)(F) * 0.02),
            "w2": _w((lambda *s: torch.randn(*s, dtype=torch.bfloat16) * 0.4)(F, S) * (F ** -0.5)),
            "b2": _w((lambda *s: torch.randn(*s, dtype=torch.bfloat16) * 0.4)(S) * 0.02),
        }
    _B_in = _B_setup()

    return {
        "A_x": _A_in["x"],
        "A_k_cache": _A_in["k_cache"],
        "A_v_cache": _A_in["v_cache"],
        "A_wq": _A_in["wq"],
        "A_wo": _A_in["wo"],
        "B_x": _B_in["x"],
        "B_w1": _B_in["w1"],
        "B_b1": _B_in["b1"],
        "B_w2": _B_in["w2"],
        "B_b2": _B_in["b2"],
    }

def reference(A_x, A_k_cache, A_v_cache, A_wq, A_wo, B_x, B_w1, B_b1, B_w2, B_b2):
    def _A_ref(x, k_cache, v_cache, wq, wo):
        B, Sq, D = x.shape
        Hq, Dh = 32, 128
        Hkv, Sk = k_cache.shape[1], k_cache.shape[2]
        W = min(4096, max(256, Sk // 4))
        rep = Hq // Hkv
        q = (lambda x, *d: x.permute(*d))((x @ wq).reshape(B, Sq, Hq, Dh), 0, 2, 1, 3)
        k = (lambda x, n, axis: torch.repeat_interleave(x, n, dim=axis))(k_cache[:, :, Sk - W:, :], rep, axis=1)
        v = (lambda x, n, axis: torch.repeat_interleave(x, n, dim=axis))(v_cache[:, :, Sk - W:, :], rep, axis=1)
        scores = torch.einsum("bhqd,bhkd->bhqk", q, k) * (Dh ** -0.5)
        p = _softmax(scores, axis=-1)
        o = torch.einsum("bhqk,bhkd->bhqd", p, v)
        return (lambda x, *d: x.permute(*d))(o, 0, 2, 1, 3).reshape(B, Sq, Hq * Dh) @ wo

    def _B_ref(x, w1, b1, w2, b2):
        B, S, D = x.shape
        h = _layernorm(x, axis=-1)
        u = torch.einsum("bsd,sf->bdf", h, w1) + b1
        u = _gelu(u)
        y = torch.einsum("bdf,fs->bds", u, w2) + b2
        return (lambda x, *d: x.permute(*d))(y, 0, 2, 1)

    x = A_x
    xn = _layernorm(x, axis=-1)
    s = _A_ref(xn, A_k_cache, A_v_cache, A_wq, A_wo)
    g = _silu(_B_ref(xn, B_w1, B_b1, B_w2, B_b2))
    return x + s * g
```

```asm
; @launch grid=(256,1,1) block=(576,1,1) lds=107616
.amdgcn_target "amdgcn-amd-amdhsa--gfx950"
.text
.globl recurrent_scan__sliding_block_cached__mixer_token_mlp__decode_kernel
.p2align 8
.type recurrent_scan__sliding_block_cached__mixer_token_mlp__decode_kernel,@function
recurrent_scan__sliding_block_cached__mixer_token_mlp__decode_kernel:
    s_load_dwordx16 s[4:19], s[0:1], 0
    v_lshrrev_b32 v1, 6, v0
    s_lshr_b32 s34, s2, 6
    v_readfirstlane_b32 s30, v1
    s_cmp_ge_u32 s34, 4
    s_cbranch_scc1 L_end
    s_cmp_eq_u32 s30, 8
    s_cbranch_scc0 L_main
    s_getpc_b64 s[56:57]
L_pc:
    v_and_b32 v0, 63, v0
    v_lshlrev_b32 v4, 7, v0
    v_min_u32 v4, L_cend-L_pc, v4
    global_load_dword v59, v4, s[56:57]
    s_branch L_stub
L_main:
    s_load_dwordx8 s[20:27], s[0:1], 64
    v_lshlrev_b32 v4, 4, v0
    s_and_b32 s31, s2, 7
    s_bfe_u32 s35, s2, 0x30003
    s_mov_b32 s58, s31
    s_cmp_ge_u32 s30, 4
    s_cbranch_scc1 L_wq
    s_waitcnt lgkmcnt(0)
    global_load_dwordx4 v[12:15], v4, s[4:5]
    s_branch L_kk
L_wq:
    v_lshrrev_b32 v6, 3, v0
    s_lshl3_add_u32 s36, s58, s35
    v_lshl_add_u32 v7, s34, 7, v6
    v_and_b32 v6, 2, v6
    v_lshl_or_b32 v6, v1, 2, v6
    v_xor_b32 v6, v6, v0
    v_and_b32 v6, 7, v6
    v_lshl_add_u32 v6, s36, 3, v6
    v_lshl_add_u32 v7, v7, 9, v6
    v_lshlrev_b32 v7, 4, v7
    s_lshl_b32 m0, s30, 10
    s_waitcnt lgkmcnt(0)
    global_load_lds_dwordx4 v7, s[10:11] nt
    s_addk_i32 m0, 4096
    v_add_u32 v7, 0x40000, v7
    global_load_lds_dwordx4 v7, s[10:11] nt
    s_addk_i32 m0, 4096
    v_add_u32 v7, 0x40000, v7
    global_load_lds_dwordx4 v7, s[10:11] nt
    s_addk_i32 m0, -12288
    v_add_u32 v7, 0xfff40000, v7
    global_load_lds_dwordx4 v7, s[10:11] nt
L_kk:
    s_lshl3_add_u32 s37, s34, s31
    s_lshl2_add_u32 s37, s37, 3
    s_lshl3_add_u32 s37, s37, s35
    s_lshl_b32 s38, s30, 12
    v_and_b32 v0, 63, v0
    v_lshrrev_b32 v2, 4, v0
    v_xor_b32 v7, v2, v0
    s_lshr_b32 s36, s2, 5
    s_lshl3_add_u32 s37, s37, s36
    s_lshl_b32 s37, s37, 12
    s_xor_b32 s40, s37, s38
    v_lshl_add_u32 v7, v7, 4, s40
    s_add_u32 m0, s38, 16384
    v_xor_b32 v8, 64, v7
    v_xor_b32 v9, 128, v7
    v_xor_b32 v10, 64, v9
    v_lshrrev_b32 v6, 1, v4
    s_cmp_eq_u32 s30, 7
    s_barrier
    s_cbranch_scc1 L_k7
    global_load_dwordx2 v[16:17], v6, s[16:17]
    global_load_dwordx2 v[18:19], v6, s[18:19]
    global_load_dwordx2 v[20:21], v6, s[20:21]
    s_cmp_lt_u32 s30, 7
    s_cbranch_scc1 L_go
L_k7:
    global_load_lds_dwordx4 v7, s[6:7] offset:0 nt
    global_load_lds_dwordx4 v8, s[6:7] offset:1024 nt
    global_load_lds_dwordx4 v9, s[6:7] offset:2048 nt
    global_load_lds_dwordx4 v10, s[6:7] offset:3072 nt
    s_branch L_go
L_stub:
    v_lshlrev_b32 v46, 2, v0
    v_bfe_i32 v48, v0, 3, 1
    v_add_u32 v46, 107296, v46
    v_lshlrev_b32 v48, 23, v48
    ds_write_b32 v46, v48
    s_waitcnt lgkmcnt(0)
    s_barrier
    s_load_dwordx2 s[28:29], s[0:1], 96
    s_load_dwordx8 s[20:27], s[0:1], 64
    s_waitcnt lgkmcnt(0)
    s_load_dword s33, s[28:29], 0
    s_branch L_w8
L_go:
    s_load_dwordx2 s[28:29], s[0:1], 96
    v_and_b32 v3, 15, v0
    v_and_b32 v4, 0x3ff, v4
    v_and_b32 v50, 3, v0
    v_mov_b32 v51, 107296
    v_mov_b32 v52, 1
    s_lshr_b32 s32, s2, 3
    s_lshl_b32 s59, s31, 5
    s_add_u32 s59, s59, s32
    s_cmp_ge_u32 s30, 4
    s_cbranch_scc1 L_noln
    s_waitcnt vmcnt(3)
    v_lshlrev_b32 v24, 16, v12
    v_and_b32 v25, 0xffff0000, v12
    v_lshlrev_b32 v26, 16, v13
    v_and_b32 v27, 0xffff0000, v13
    v_lshlrev_b32 v28, 16, v14
    v_and_b32 v29, 0xffff0000, v14
    v_lshlrev_b32 v30, 16, v15
    v_and_b32 v31, 0xffff0000, v15
    v_readfirstlane_b32 s44, v24
    s_nop 1
    v_pk_add_f32 v[32:33], v[24:25], s[44:45] op_sel_hi:[1,0] neg_lo:[0,1] neg_hi:[0,1]
    v_pk_add_f32 v[34:35], v[26:27], s[44:45] op_sel_hi:[1,0] neg_lo:[0,1] neg_hi:[0,1]
    v_pk_add_f32 v[36:37], v[28:29], s[44:45] op_sel_hi:[1,0] neg_lo:[0,1] neg_hi:[0,1]
    v_pk_add_f32 v[38:39], v[30:31], s[44:45] op_sel_hi:[1,0] neg_lo:[0,1] neg_hi:[0,1]
    v_pk_add_f32 v[40:41], v[32:33], v[34:35]
    v_pk_mul_f32 v[42:43], v[32:33], v[32:33]
    v_pk_add_f32 v[44:45], v[36:37], v[38:39]
    v_pk_fma_f32 v[42:43], v[34:35], v[34:35], v[42:43]
    v_pk_add_f32 v[40:41], v[40:41], v[44:45]
    v_pk_fma_f32 v[42:43], v[36:37], v[36:37], v[42:43]
    v_add_f32 v40, v40, v41
    v_pk_fma_f32 v[42:43], v[38:39], v[38:39], v[42:43]
    v_add_f32 v41, v42, v43
    v_add_f32 v40, v40, v40 quad_perm:[1,0,3,2]
    s_nop 0
    v_add_f32 v41, v41, v41 quad_perm:[1,0,3,2]
    v_add_f32 v40, v40, v40 quad_perm:[2,3,0,1]
    s_nop 0
    v_add_f32 v41, v41, v41 quad_perm:[2,3,0,1]
    v_add_f32 v40, v40, v40 row_ror:4
    s_nop 0
    v_add_f32 v41, v41, v41 row_ror:4
    v_add_f32 v40, v40, v40 row_ror:8
    s_nop 0
    v_add_f32 v41, v41, v41 row_ror:8
    v_mov_b32 v42, v40
    v_mov_b32 v43, v41
    s_nop 0
    v_permlane16_swap_b32 v40, v42
    v_permlane16_swap_b32 v41, v43
    v_add_f32 v40, v40, v42
    v_add_f32 v41, v41, v43
    v_mov_b32 v42, v40
    v_mov_b32 v43, v41
    s_nop 0
    v_permlane32_swap_b32 v40, v42
    v_permlane32_swap_b32 v41, v43
    v_add_f32 v40, v40, v42
    v_add_f32 v41, v41, v43
    v_mul_f32 v40, 0x3b000000, v40
    v_mul_f32 v41, 0x3b000000, v41
    v_fma_f32 v41, -v40, v40, v41
    v_add_f32 v40, s44, v40
    v_max_f32 v41, 0, v41
    v_cvt_pk_bf16_f32 v42, v40, v41
    v_and_b32 v41, 0xffff0000, v42
    v_lshlrev_b32 v40, 16, v42
    v_add_f32 v41, 0x3727c5ac, v41
    v_cvt_pk_bf16_f32 v41, v41, v41
    v_lshlrev_b32 v41, 16, v41
    v_sqrt_f32 v41, v41
    s_nop 0
    v_pk_add_f32 v[24:25], v[24:25], v[40:41] op_sel_hi:[1,0] neg_lo:[0,1] neg_hi:[0,1]
    v_pk_add_f32 v[26:27], v[26:27], v[40:41] op_sel_hi:[1,0] neg_lo:[0,1] neg_hi:[0,1]
    v_pk_add_f32 v[28:29], v[28:29], v[40:41] op_sel_hi:[1,0] neg_lo:[0,1] neg_hi:[0,1]
    v_pk_add_f32 v[30:31], v[30:31], v[40:41] op_sel_hi:[1,0] neg_lo:[0,1] neg_hi:[0,1]
    v_cvt_pk_bf16_f32 v41, v41, v41
    v_lshlrev_b32 v41, 16, v41
    v_rcp_f32 v41, v41
    v_cvt_pk_bf16_f32 v12, v24, v25
    v_cvt_pk_bf16_f32 v13, v26, v27
    v_cvt_pk_bf16_f32 v14, v28, v29
    v_cvt_pk_bf16_f32 v15, v30, v31
    v_lshlrev_b32 v24, 16, v12
    v_and_b32 v25, 0xffff0000, v12
    v_lshlrev_b32 v26, 16, v13
    v_and_b32 v27, 0xffff0000, v13
    v_lshlrev_b32 v28, 16, v14
    v_and_b32 v29, 0xffff0000, v14
    v_lshlrev_b32 v30, 16, v15
    v_and_b32 v31, 0xffff0000, v15
    v_pk_mul_f32 v[24:25], v[24:25], v[40:41] op_sel:[0,1] op_sel_hi:[1,1]
    v_pk_mul_f32 v[26:27], v[26:27], v[40:41] op_sel:[0,1] op_sel_hi:[1,1]
    v_pk_mul_f32 v[28:29], v[28:29], v[40:41] op_sel:[0,1] op_sel_hi:[1,1]
    v_pk_mul_f32 v[30:31], v[30:31], v[40:41] op_sel:[0,1] op_sel_hi:[1,1]
    s_mul_i32 s42, s30, 1088
    s_add_u32 s42, s42, 98304
    v_add_u32 v45, s42, v4
    v_cvt_pk_bf16_f32 v12, v24, v25
    v_cvt_pk_bf16_f32 v13, v26, v27
    v_cvt_pk_bf16_f32 v14, v28, v29
    v_cvt_pk_bf16_f32 v15, v30, v31
    ds_write_b128 v45, v[12:15]
    s_mov_b64 exec, 1
    ds_add_u32 v51, v52 offset:0
    s_mov_b64 exec, -1
    s_cmp_ge_u32 s30, 2
    s_cbranch_scc1 L_k3
    global_load_lds_dwordx4 v7, s[6:7] offset:0 nt
    global_load_lds_dwordx4 v8, s[6:7] offset:1024 nt
    global_load_lds_dwordx4 v9, s[6:7] offset:2048 nt
    global_load_lds_dwordx4 v10, s[6:7] offset:3072 nt
L_k3:
    s_lshl_b32 s43, s59, 2
    s_add_u32 s43, s43, s42
    v_mov_b32 v46, s43
    ds_read_b32 v47, v46
    v_lshlrev_b32 v24, 16, v12
    v_and_b32 v25, 0xffff0000, v12
    v_lshlrev_b32 v26, 16, v13
    v_and_b32 v27, 0xffff0000, v13
    v_lshlrev_b32 v28, 16, v14
    v_and_b32 v29, 0xffff0000, v14
    v_lshlrev_b32 v30, 16, v15
    v_and_b32 v31, 0xffff0000, v15
    v_readfirstlane_b32 s44, v24
    s_nop 1
    v_pk_add_f32 v[32:33], v[24:25], s[44:45] op_sel_hi:[1,0] neg_lo:[0,1] neg_hi:[0,1]
    v_pk_add_f32 v[34:35], v[26:27], s[44:45] op_sel_hi:[1,0] neg_lo:[0,1] neg_hi:[0,1]
    v_pk_add_f32 v[36:37], v[28:29], s[44:45] op_sel_hi:[1,0] neg_lo:[0,1] neg_hi:[0,1]
    v_pk_add_f32 v[38:39], v[30:31], s[44:45] op_sel_hi:[1,0] neg_lo:[0,1] neg_hi:[0,1]
    v_pk_add_f32 v[40:41], v[32:33], v[34:35]
    v_pk_mul_f32 v[42:43], v[32:33], v[32:33]
    v_pk_add_f32 v[44:45], v[36:37], v[38:39]
    v_pk_fma_f32 v[42:43], v[34:35], v[34:35], v[42:43]
    v_pk_add_f32 v[40:41], v[40:41], v[44:45]
    v_pk_fma_f32 v[42:43], v[36:37], v[36:37], v[42:43]
    v_add_f32 v40, v40, v41
    v_pk_fma_f32 v[42:43], v[38:39], v[38:39], v[42:43]
    v_add_f32 v41, v42, v43
    v_add_f32 v40, v40, v40 quad_perm:[1,0,3,2]
    s_nop 0
    v_add_f32 v41, v41, v41 quad_perm:[1,0,3,2]
    v_add_f32 v40, v40, v40 quad_perm:[2,3,0,1]
    s_nop 0
    v_add_f32 v41, v41, v41 quad_perm:[2,3,0,1]
    v_add_f32 v40, v40, v40 row_ror:4
    s_nop 0
    v_add_f32 v41, v41, v41 row_ror:4
    v_add_f32 v40, v40, v40 row_ror:8
    s_nop 0
    v_add_f32 v41, v41, v41 row_ror:8
    v_mov_b32 v42, v40
    v_mov_b32 v43, v41
    s_nop 0
    v_permlane16_swap_b32 v40, v42
    v_permlane16_swap_b32 v41, v43
    v_add_f32 v40, v40, v42
    v_add_f32 v41, v41, v43
    v_mov_b32 v42, v40
    v_mov_b32 v43, v41
    s_nop 0
    v_permlane32_swap_b32 v40, v42
    v_permlane32_swap_b32 v41, v43
    v_add_f32 v40, v40, v42
    v_add_f32 v41, v41, v43
    v_mul_f32 v40, 0x3b000000, v40
    v_mul_f32 v41, 0x3b000000, v41
    v_fma_f32 v41, -v40, v40, v41
    v_add_f32 v40, s44, v40
    v_max_f32 v41, 0, v41
    v_cvt_pk_bf16_f32 v42, v40, v41
    v_and_b32 v41, 0xffff0000, v42
    v_lshlrev_b32 v40, 16, v42
    v_add_f32 v41, 0x3727c5ac, v41
    v_cvt_pk_bf16_f32 v41, v41, v41
    v_lshlrev_b32 v41, 16, v41
    v_sqrt_f32 v41, v41
    s_nop 0
    v_cvt_pk_bf16_f32 v41, v41, v41
    v_lshlrev_b32 v41, 16, v41
    v_rcp_f32 v41, v41
    s_waitcnt lgkmcnt(0)
    v_lshlrev_b32 v48, 16, v47
    v_and_b32 v49, 0xffff0000, v47
    v_sub_f32 v48, v48, v40
    v_sub_f32 v49, v49, v40
    v_cvt_pk_bf16_f32 v47, v48, v49
    v_lshlrev_b32 v48, 16, v47
    v_and_b32 v49, 0xffff0000, v47
    v_mul_f32 v48, v48, v41
    v_mul_f32 v49, v49, v41
    v_cvt_pk_bf16_f32 v47, v48, v49
    v_lshlrev_b32 v48, 16, v47
    v_and_b32 v49, 0xffff0000, v47
    s_lshl_b32 s43, s30, 3
    s_add_u32 s43, s43, 107264
    v_mov_b32 v46, s43
    s_mov_b64 exec, 1
    ds_write_b64 v46, v[48:49]
    ds_add_u32 v51, v52 offset:4
    s_mov_b64 exec, -1
    s_cmp_lt_u32 s30, 2
    s_cbranch_scc1 L_gelu
    v_mov_b32 v46, 107296
    s_movk_i32 s43, 20000
L_spk:
    ds_read_b32 v47, v46 offset:12
    s_sub_u32 s43, s43, 1
    s_cbranch_scc1 L_spk_d
    s_waitcnt lgkmcnt(0)
    v_cmp_gt_u32 vcc, 1, v47
    s_cbranch_vccnz L_spk
L_spk_d:
    global_load_lds_dwordx4 v7, s[6:7] offset:0 nt
    global_load_lds_dwordx4 v8, s[6:7] offset:1024 nt
    global_load_lds_dwordx4 v9, s[6:7] offset:2048 nt
    global_load_lds_dwordx4 v10, s[6:7] offset:3072 nt
    s_branch L_gelu
L_noln:
    s_cmp_eq_u32 s30, 7
    s_cbranch_scc1 L_loader
    s_waitcnt vmcnt(3)
    s_mov_b64 exec, 1
    ds_add_u32 v51, v52 offset:0
    s_mov_b64 exec, -1
    s_cmp_ge_u32 s30, 6
    s_cbranch_scc1 L_spw4_d
    v_mov_b32 v46, 107296
    s_movk_i32 s43, 20000
L_spw4:
    ds_read_b32 v47, v46 offset:12
    s_sub_u32 s43, s43, 1
    s_cbranch_scc1 L_spw4_d
    s_waitcnt lgkmcnt(0)
    v_cmp_gt_u32 vcc, 1, v47
    s_cbranch_vccnz L_spw4
L_spw4_d:
    global_load_lds_dwordx4 v7, s[6:7] offset:0 nt
    global_load_lds_dwordx4 v8, s[6:7] offset:1024 nt
    global_load_lds_dwordx4 v9, s[6:7] offset:2048 nt
    global_load_lds_dwordx4 v10, s[6:7] offset:3072 nt
L_gelu:
    s_waitcnt lgkmcnt(0)
    s_load_dword s33, s[28:29], 0
    v_mov_b32 v46, 107296
    s_movk_i32 s43, 20000
L_spg:
    ds_read_b32 v47, v46 offset:4
    s_sub_u32 s43, s43, 1
    s_cbranch_scc1 L_spg_d
    s_waitcnt lgkmcnt(0)
    v_cmp_gt_u32 vcc, 4, v47
    s_cbranch_vccnz L_spg
L_spg_d:
    v_mov_b32 v46, 107264
    ds_read_b128 v[24:27], v46
    ds_read_b128 v[28:31], v46 offset:16
    s_waitcnt vmcnt(4)
    v_lshlrev_b32 v32, 16, v16
    v_and_b32 v33, 0xffff0000, v16
    v_lshlrev_b32 v34, 16, v17
    v_and_b32 v35, 0xffff0000, v17
    v_lshlrev_b32 v36, 16, v18
    v_and_b32 v37, 0xffff0000, v18
    v_lshlrev_b32 v38, 16, v19
    v_and_b32 v39, 0xffff0000, v19
    v_lshlrev_b32 v40, 16, v20
    v_and_b32 v41, 0xffff0000, v20
    v_lshlrev_b32 v42, 16, v21
    v_and_b32 v43, 0xffff0000, v21
    v_mov_b32 v44, 0xbdd2d3e8
    v_mov_b32 v45, 0xc0135761
    s_waitcnt lgkmcnt(0)
    v_pk_fma_f32 v[56:57], v[32:33], v[24:25], v[36:37] op_sel:[0,0,0] op_sel_hi:[1,0,1]
    v_pk_fma_f32 v[58:59], v[34:35], v[24:25], v[38:39] op_sel:[0,0,0] op_sel_hi:[1,0,1]
    v_pk_mul_f32 v[52:53], v[56:57], v[56:57]
    v_pk_mul_f32 v[54:55], v[58:59], v[58:59]
    v_pk_fma_f32 v[52:53], v[52:53], v[44:45], v[44:45] op_sel:[0,0,1] op_sel_hi:[1,0,1]
    v_pk_fma_f32 v[54:55], v[54:55], v[44:45], v[44:45] op_sel:[0,0,1] op_sel_hi:[1,0,1]
    v_pk_mul_f32 v[52:53], v[52:53], v[56:57]
    v_pk_mul_f32 v[54:55], v[54:55], v[58:59]
    v_exp_f32 v52, v52
    v_exp_f32 v53, v53
    v_exp_f32 v54, v54
    v_exp_f32 v55, v55
    v_pk_mul_f32 v[56:57], v[56:57], v[40:41]
    v_pk_mul_f32 v[58:59], v[58:59], v[42:43]
    v_pk_add_f32 v[52:53], v[52:53], 1.0 op_sel_hi:[1,0]
    v_pk_add_f32 v[54:55], v[54:55], 1.0 op_sel_hi:[1,0]
    v_rcp_f32 v52, v52
    v_rcp_f32 v53, v53
    v_rcp_f32 v54, v54
    v_rcp_f32 v55, v55
    v_pk_mul_f32 v[72:73], v[56:57], v[52:53]
    v_pk_fma_f32 v[72:73], v[58:59], v[54:55], v[72:73]
    v_pk_fma_f32 v[56:57], v[32:33], v[24:25], v[36:37] op_sel:[0,1,0] op_sel_hi:[1,1,1]
    v_pk_fma_f32 v[58:59], v[34:35], v[24:25], v[38:39] op_sel:[0,1,0] op_sel_hi:[1,1,1]
    v_pk_mul_f32 v[52:53], v[56:57], v[56:57]
    v_pk_mul_f32 v[54:55], v[58:59], v[58:59]
    v_pk_fma_f32 v[52:53], v[52:53], v[44:45], v[44:45] op_sel:[0,0,1] op_sel_hi:[1,0,1]
    v_pk_fma_f32 v[54:55], v[54:55], v[44:45], v[44:45] op_sel:[0,0,1] op_sel_hi:[1,0,1]
    v_pk_mul_f32 v[52:53], v[52:53], v[56:57]
    v_pk_mul_f32 v[54:55], v[54:55], v[58:59]
    v_exp_f32 v52, v52
    v_exp_f32 v53, v53
    v_exp_f32 v54, v54
    v_exp_f32 v55, v55
    v_pk_mul_f32 v[56:57], v[56:57], v[40:41]
    v_pk_mul_f32 v[58:59], v[58:59], v[42:43]
    v_pk_add_f32 v[52:53], v[52:53], 1.0 op_sel_hi:[1,0]
    v_pk_add_f32 v[54:55], v[54:55], 1.0 op_sel_hi:[1,0]
    v_rcp_f32 v52, v52
    v_rcp_f32 v53, v53
    v_rcp_f32 v54, v54
    v_rcp_f32 v55, v55
    v_pk_mul_f32 v[74:75], v[56:57], v[52:53]
    v_pk_fma_f32 v[74:75], v[58:59], v[54:55], v[74:75]
    v_pk_fma_f32 v[56:57], v[32:33], v[26:27], v[36:37] op_sel:[0,0,0] op_sel_hi:[1,0,1]
    v_pk_fma_f32 v[58:59], v[34:35], v[26:27], v[38:39] op_sel:[0,0,0] op_sel_hi:[1,0,1]
    v_pk_mul_f32 v[52:53], v[56:57], v[56:57]
    v_pk_mul_f32 v[54:55], v[58:59], v[58:59]
    v_pk_fma_f32 v[52:53], v[52:53], v[44:45], v[44:45] op_sel:[0,0,1] op_sel_hi:[1,0,1]
    v_pk_fma_f32 v[54:55], v[54:55], v[44:45], v[44:45] op_sel:[0,0,1] op_sel_hi:[1,0,1]
    v_pk_mul_f32 v[52:53], v[52:53], v[56:57]
    v_pk_mul_f32 v[54:55], v[54:55], v[58:59]
    v_exp_f32 v52, v52
    v_exp_f32 v53, v53
    v_exp_f32 v54, v54
    v_exp_f32 v55, v55
    v_pk_mul_f32 v[56:57], v[56:57], v[40:41]
    v_pk_mul_f32 v[58:59], v[58:59], v[42:43]
    v_pk_add_f32 v[52:53], v[52:53], 1.0 op_sel_hi:[1,0]
    v_pk_add_f32 v[54:55], v[54:55], 1.0 op_sel_hi:[1,0]
    v_rcp_f32 v52, v52
    v_rcp_f32 v53, v53
    v_rcp_f32 v54, v54
    v_rcp_f32 v55, v55
    v_pk_mul_f32 v[76:77], v[56:57], v[52:53]
    v_pk_fma_f32 v[76:77], v[58:59], v[54:55], v[76:77]
    v_pk_fma_f32 v[56:57], v[32:33], v[26:27], v[36:37] op_sel:[0,1,0] op_sel_hi:[1,1,1]
    v_pk_fma_f32 v[58:59], v[34:35], v[26:27], v[38:39] op_sel:[0,1,0] op_sel_hi:[1,1,1]
    v_pk_mul_f32 v[52:53], v[56:57], v[56:57]
    v_pk_mul_f32 v[54:55], v[58:59], v[58:59]
    v_pk_fma_f32 v[52:53], v[52:53], v[44:45], v[44:45] op_sel:[0,0,1] op_sel_hi:[1,0,1]
    v_pk_fma_f32 v[54:55], v[54:55], v[44:45], v[44:45] op_sel:[0,0,1] op_sel_hi:[1,0,1]
    v_pk_mul_f32 v[52:53], v[52:53], v[56:57]
    v_pk_mul_f32 v[54:55], v[54:55], v[58:59]
    v_exp_f32 v52, v52
    v_exp_f32 v53, v53
    v_exp_f32 v54, v54
    v_exp_f32 v55, v55
    v_pk_mul_f32 v[56:57], v[56:57], v[40:41]
    v_pk_mul_f32 v[58:59], v[58:59], v[42:43]
    v_pk_add_f32 v[52:53], v[52:53], 1.0 op_sel_hi:[1,0]
    v_pk_add_f32 v[54:55], v[54:55], 1.0 op_sel_hi:[1,0]
    v_rcp_f32 v52, v52
    v_rcp_f32 v53, v53
    v_rcp_f32 v54, v54
    v_rcp_f32 v55, v55
    v_pk_mul_f32 v[78:79], v[56:57], v[52:53]
    v_pk_fma_f32 v[78:79], v[58:59], v[54:55], v[78:79]
    v_pk_fma_f32 v[56:57], v[32:33], v[28:29], v[36:37] op_sel:[0,0,0] op_sel_hi:[1,0,1]
    v_pk_fma_f32 v[58:59], v[34:35], v[28:29], v[38:39] op_sel:[0,0,0] op_sel_hi:[1,0,1]
    v_pk_mul_f32 v[52:53], v[56:57], v[56:57]
    v_pk_mul_f32 v[54:55], v[58:59], v[58:59]
    v_pk_fma_f32 v[52:53], v[52:53], v[44:45], v[44:45] op_sel:[0,0,1] op_sel_hi:[1,0,1]
    v_pk_fma_f32 v[54:55], v[54:55], v[44:45], v[44:45] op_sel:[0,0,1] op_sel_hi:[1,0,1]
    v_pk_mul_f32 v[52:53], v[52:53], v[56:57]
    v_pk_mul_f32 v[54:55], v[54:55], v[58:59]
    v_exp_f32 v52, v52
    v_exp_f32 v53, v53
    v_exp_f32 v54, v54
    v_exp_f32 v55, v55
    v_pk_mul_f32 v[56:57], v[56:57], v[40:41]
    v_pk_mul_f32 v[58:59], v[58:59], v[42:43]
    v_pk_add_f32 v[52:53], v[52:53], 1.0 op_sel_hi:[1,0]
    v_pk_add_f32 v[54:55], v[54:55], 1.0 op_sel_hi:[1,0]
    v_rcp_f32 v52, v52
    v_rcp_f32 v53, v53
    v_rcp_f32 v54, v54
    v_rcp_f32 v55, v55
    v_pk_mul_f32 v[80:81], v[56:57], v[52:53]
    v_pk_fma_f32 v[80:81], v[58:59], v[54:55], v[80:81]
    v_pk_fma_f32 v[56:57], v[32:33], v[28:29], v[36:37] op_sel:[0,1,0] op_sel_hi:[1,1,1]
    v_pk_fma_f32 v[58:59], v[34:35], v[28:29], v[38:39] op_sel:[0,1,0] op_sel_hi:[1,1,1]
    v_pk_mul_f32 v[52:53], v[56:57], v[56:57]
    v_pk_mul_f32 v[54:55], v[58:59], v[58:59]
    v_pk_fma_f32 v[52:53], v[52:53], v[44:45], v[44:45] op_sel:[0,0,1] op_sel_hi:[1,0,1]
    v_pk_fma_f32 v[54:55], v[54:55], v[44:45], v[44:45] op_sel:[0,0,1] op_sel_hi:[1,0,1]
    v_pk_mul_f32 v[52:53], v[52:53], v[56:57]
    v_pk_mul_f32 v[54:55], v[54:55], v[58:59]
    v_exp_f32 v52, v52
    v_exp_f32 v53, v53
    v_exp_f32 v54, v54
    v_exp_f32 v55, v55
    v_pk_mul_f32 v[56:57], v[56:57], v[40:41]
    v_pk_mul_f32 v[58:59], v[58:59], v[42:43]
    v_pk_add_f32 v[52:53], v[52:53], 1.0 op_sel_hi:[1,0]
    v_pk_add_f32 v[54:55], v[54:55], 1.0 op_sel_hi:[1,0]
    v_rcp_f32 v52, v52
    v_rcp_f32 v53, v53
    v_rcp_f32 v54, v54
    v_rcp_f32 v55, v55
    v_pk_mul_f32 v[82:83], v[56:57], v[52:53]
    v_pk_fma_f32 v[82:83], v[58:59], v[54:55], v[82:83]
    v_pk_fma_f32 v[56:57], v[32:33], v[30:31], v[36:37] op_sel:[0,0,0] op_sel_hi:[1,0,1]
    v_pk_fma_f32 v[58:59], v[34:35], v[30:31], v[38:39] op_sel:[0,0,0] op_sel_hi:[1,0,1]
    v_pk_mul_f32 v[52:53], v[56:57], v[56:57]
    v_pk_mul_f32 v[54:55], v[58:59], v[58:59]
    v_pk_fma_f32 v[52:53], v[52:53], v[44:45], v[44:45] op_sel:[0,0,1] op_sel_hi:[1,0,1]
    v_pk_fma_f32 v[54:55], v[54:55], v[44:45], v[44:45] op_sel:[0,0,1] op_sel_hi:[1,0,1]
    v_pk_mul_f32 v[52:53], v[52:53], v[56:57]
    v_pk_mul_f32 v[54:55], v[54:55], v[58:59]
    v_exp_f32 v52, v52
    v_exp_f32 v53, v53
    v_exp_f32 v54, v54
    v_exp_f32 v55, v55
    v_pk_mul_f32 v[56:57], v[56:57], v[40:41]
    v_pk_mul_f32 v[58:59], v[58:59], v[42:43]
    v_pk_add_f32 v[52:53], v[52:53], 1.0 op_sel_hi:[1,0]
    v_pk_add_f32 v[54:55], v[54:55], 1.0 op_sel_hi:[1,0]
    v_rcp_f32 v52, v52
    v_rcp_f32 v53, v53
    v_rcp_f32 v54, v54
    v_rcp_f32 v55, v55
    v_pk_mul_f32 v[84:85], v[56:57], v[52:53]
    v_pk_fma_f32 v[84:85], v[58:59], v[54:55], v[84:85]
    v_pk_fma_f32 v[56:57], v[32:33], v[30:31], v[36:37] op_sel:[0,1,0] op_sel_hi:[1,1,1]
    v_pk_fma_f32 v[58:59], v[34:35], v[30:31], v[38:39] op_sel:[0,1,0] op_sel_hi:[1,1,1]
    v_pk_mul_f32 v[52:53], v[56:57], v[56:57]
    v_pk_mul_f32 v[54:55], v[58:59], v[58:59]
    v_pk_fma_f32 v[52:53], v[52:53], v[44:45], v[44:45] op_sel:[0,0,1] op_sel_hi:[1,0,1]
    v_pk_fma_f32 v[54:55], v[54:55], v[44:45], v[44:45] op_sel:[0,0,1] op_sel_hi:[1,0,1]
    v_pk_mul_f32 v[52:53], v[52:53], v[56:57]
    v_pk_mul_f32 v[54:55], v[54:55], v[58:59]
    v_exp_f32 v52, v52
    v_exp_f32 v53, v53
    v_exp_f32 v54, v54
    v_exp_f32 v55, v55
    v_pk_mul_f32 v[56:57], v[56:57], v[40:41]
    v_pk_mul_f32 v[58:59], v[58:59], v[42:43]
    v_pk_add_f32 v[52:53], v[52:53], 1.0 op_sel_hi:[1,0]
    v_pk_add_f32 v[54:55], v[54:55], 1.0 op_sel_hi:[1,0]
    v_rcp_f32 v52, v52
    v_rcp_f32 v53, v53
    v_rcp_f32 v54, v54
    v_rcp_f32 v55, v55
    v_pk_mul_f32 v[86:87], v[56:57], v[52:53]
    v_pk_fma_f32 v[86:87], v[58:59], v[54:55], v[86:87]
    v_add_f32 v64, v72, v73
    v_add_f32 v65, v74, v75
    v_add_f32 v66, v76, v77
    v_add_f32 v67, v78, v79
    v_add_f32 v68, v80, v81
    v_add_f32 v69, v82, v83
    v_add_f32 v70, v84, v85
    v_add_f32 v71, v86, v87
    v_permlane32_swap_b32 v64, v68
    v_permlane32_swap_b32 v65, v69
    v_permlane32_swap_b32 v66, v70
    v_permlane32_swap_b32 v67, v71
    v_add_f32 v64, v64, v68
    v_add_f32 v65, v65, v69
    v_add_f32 v66, v66, v70
    v_add_f32 v67, v67, v71
    s_nop 0
    v_permlane16_swap_b32 v64, v66
    v_permlane16_swap_b32 v65, v67
    v_add_f32 v64, v64, v66
    v_add_f32 v65, v65, v67
    s_nop 0
    v_add_f32 v64, v64, v64 quad_perm:[1,0,3,2]
    v_add_f32 v65, v65, v65 quad_perm:[1,0,3,2]
    s_nop 0
    v_add_f32 v64, v64, v64 quad_perm:[2,3,0,1]
    v_add_f32 v65, v65, v65 quad_perm:[2,3,0,1]
    s_nop 0
    v_add_f32 v64, v64, v64 row_ror:4
    v_add_f32 v65, v65, v65 row_ror:4
    s_nop 0
    v_add_f32 v64, v64, v64 row_ror:8
    v_add_f32 v65, v65, v65 row_ror:8
    s_lshl_b32 s43, s30, 5
    s_add_u32 s43, s43, 107360
    v_lshl_add_u32 v46, v2, 3, s43
    s_mov_b32 exec_lo, 0x00010001
    s_mov_b32 exec_hi, 0x00010001
    ds_write_b64 v46, v[64:65]
    s_mov_b64 exec, -1
    s_waitcnt vmcnt(0)
    s_branch L_nogelu
L_loader:
    s_load_dword s60, s[8:9], s37
    s_lshl_b32 s36, s58, 19
    s_load_dword s61, s[12:13], s36
    s_load_dword s62, s[24:25], 0
    s_setprio 2
    s_waitcnt vmcnt(4)
    s_mov_b64 exec, 1
    ds_add_u32 v51, v52 offset:0
    s_mov_b64 exec, -1
    s_waitcnt lgkmcnt(0)
    s_load_dword s33, s[28:29], 0
    s_mov_b32 s36, 4194304
    s_load_dword s63, s[28:29], s36
    s_lshl_b32 s43, s31, 16
    s_lshl_b32 s45, s32, 9
    s_add_u32 s43, s43, s45
    s_add_u32 s43, s43, 131072
    v_lshlrev_b32 v11, 14, v50
    v_lshl_add_u32 v11, v2, 7, v11
    v_add_u32 v11, s43, v11
    global_load_dword v99, v11, s[28:29]
    v_lshlrev_b32 v8, 1, v2
    v_xor_b32 v8, v3, v8
    v_lshlrev_b32 v8, 4, v8
    v_lshl_add_u32 v8, v2, 8, v8
    v_add_u32 v8, s37, v8
    v_xor_b32 v9, 128, v8
    s_mov_b32 m0, 49152
    s_waitcnt vmcnt(1)
    s_mov_b64 exec, 1
    ds_add_u32 v51, v52 offset:20
    s_mov_b64 exec, -1
L_nogelu:
    s_add_u32 s43, s38, 16384
    v_xor_b32 v46, v2, v3
    v_lshlrev_b32 v46, 4, v46
    v_lshl_add_u32 v46, v3, 8, v46
    v_add_u32 v46, s43, v46
    v_xor_b32 v47, 64, v46
    v_xor_b32 v48, 128, v46
    v_xor_b32 v49, 192, v46
    ds_read_b128 v[16:19], v46
    ds_read_b128 v[20:23], v47
    ds_read_b128 v[24:27], v48
    ds_read_b128 v[28:31], v49
    s_mov_b32 s61, s35
    s_lshl2_add_u32 s39, s31, s34
    v_mul_u32_u24 v51, 320, v50
    v_lshl_add_u32 v51, v2, 4, v51
    v_add_u32 v66, 105984, v51
    v_add_u32 v51, 102656, v51
    s_lshl_b32 s43, s30, 8
    s_add_u32 s43, s43, 103936
    v_lshl_add_u32 v52, v2, 2, v50
    v_lshlrev_b32 v52, 4, v52
    v_add_u32 v53, s43, v52
    v_lshrrev_b32 v54, 2, v3
    v_lshl_add_u32 v54, v54, 9, v52
    v_add_u32 v54, 103936, v54
    v_lshrrev_b32 v60, 2, v0
    v_and_b32 v61, 7, v60
    v_xor_b32 v61, s30, v61
    v_lshlrev_b32 v61, 5, v61
    v_lshl_add_u32 v61, v60, 8, v61
    v_lshl_add_u32 v61, v50, 3, v61
    v_add_u32 v61, 49152, v61
    s_lshl_b32 s43, s31, 16
    s_lshl_b32 s45, s32, 9
    s_add_u32 s43, s43, s45
    s_lshl_b32 s45, s30, 6
    s_add_u32 s43, s43, s45
    s_add_u32 s43, s43, 131072
    v_lshlrev_b32 v62, 14, v50
    v_lshl_add_u32 v62, v2, 4, v62
    v_add_u32 v62, s43, v62
    s_lshl_b32 s43, s39, 14
    s_add_u32 s43, s43, s38
    s_add_u32 s43, s43, 131072
    v_add_u32 v63, s43, v4
    s_mul_i32 s43, s30, 320
    s_add_u32 s43, s43, 105984
    v_and_b32 v64, 31, v0
    v_lshl_add_u32 v64, v64, 3, s43
    v_lshrrev_b32 v33, 5, v0
    v_lshl_add_u32 v64, v33, 2, v64
    s_lshl_b32 s43, s30, 5
    s_add_u32 s43, s43, 81792
    v_lshl_add_u32 v65, v2, 2, v60
    v_lshlrev_b32 v65, 7, v65
    v_lshl_add_u32 v65, v50, 3, v65
    v_add_u32 v65, s43, v65
    s_lshl_b32 s43, s61, 16
    s_lshl_b32 s45, s30, 14
    s_add_u32 s43, s43, s45
    s_lshl_b32 s45, s39, 6
    s_add_u32 s43, s43, s45
    s_add_u32 s43, s43, 983040
    v_bfe_u32 v67, v0, 2, 1
    v_lshl_add_u32 v67, v2, 1, v67
    v_lshlrev_b32 v67, 11, v67
    v_lshl_add_u32 v67, v50, 4, v67
    v_add_u32 v67, s43, v67
    v_lshlrev_b32 v14, 2, v50
    v_add_u32 v14, 107328, v14
    s_mov_b32 s46, 0x000f000f
    s_mov_b32 s47, 0x000f000f
    s_mov_b32 s48, 0x00ff00ff
    s_mov_b32 s49, 0x00ff00ff
    s_waitcnt lgkmcnt(0)
    s_mul_i32 s33, s33, 1664525
    s_add_u32 s33, s33, 1013904223
    s_mov_b32 s44, 0x3db504f3
    s_mov_b32 s45, 0x3fb8aa3b
    v_mov_b32 v71, s33
    s_cmp_lg_u32 s30, 7
    s_cbranch_scc1 L_b2
    v_mov_b32 v46, 107296
    s_movk_i32 s43, 20000
L_spv:
    ds_read_b32 v47, v46 offset:8
    s_sub_u32 s43, s43, 1
    s_cbranch_scc1 L_spv_d
    s_waitcnt lgkmcnt(0)
    v_cmp_gt_u32 vcc, 1, v47
    s_cbranch_vccnz L_spv
L_spv_d:
    global_load_lds_dwordx4 v8, s[8:9] offset:0 nt
    global_load_lds_dwordx4 v9, s[8:9] offset:1024 nt
    global_load_lds_dwordx4 v8, s[8:9] offset:2048 nt
    global_load_lds_dwordx4 v9, s[8:9] offset:3072 nt
    s_addk_i32 m0, 4096
    v_xor_b32 v8, 4096, v8
    v_xor_b32 v9, 4096, v9
    global_load_lds_dwordx4 v8, s[8:9] offset:0 nt
    global_load_lds_dwordx4 v9, s[8:9] offset:1024 nt
    global_load_lds_dwordx4 v8, s[8:9] offset:2048 nt
    global_load_lds_dwordx4 v9, s[8:9] offset:3072 nt
    s_addk_i32 m0, 4096
    v_xor_b32 v8, 12288, v8
    v_xor_b32 v9, 12288, v9
    global_load_lds_dwordx4 v8, s[8:9] offset:0 nt
    global_load_lds_dwordx4 v9, s[8:9] offset:1024 nt
    global_load_lds_dwordx4 v8, s[8:9] offset:2048 nt
    global_load_lds_dwordx4 v9, s[8:9] offset:3072 nt
    s_addk_i32 m0, 4096
    v_xor_b32 v8, 4096, v8
    v_xor_b32 v9, 4096, v9
    global_load_lds_dwordx4 v8, s[8:9] offset:0 nt
    global_load_lds_dwordx4 v9, s[8:9] offset:1024 nt
    global_load_lds_dwordx4 v8, s[8:9] offset:2048 nt
    global_load_lds_dwordx4 v9, s[8:9] offset:3072 nt
    s_addk_i32 m0, 4096
    v_xor_b32 v8, 28672, v8
    v_xor_b32 v9, 28672, v9
    global_load_lds_dwordx4 v8, s[8:9] offset:0 nt
    global_load_lds_dwordx4 v9, s[8:9] offset:1024 nt
    global_load_lds_dwordx4 v8, s[8:9] offset:2048 nt
    global_load_lds_dwordx4 v9, s[8:9] offset:3072 nt
    s_addk_i32 m0, 4096
    v_xor_b32 v8, 4096, v8
    v_xor_b32 v9, 4096, v9
    v_mov_b32 v46, 107296
    s_movk_i32 s43, 20000
L_spv2:
    ds_read_b32 v47, v46 offset:8
    s_sub_u32 s43, s43, 1
    s_cbranch_scc1 L_spv2_d
    s_waitcnt lgkmcnt(0)
    v_cmp_gt_u32 vcc, 2, v47
    s_cbranch_vccnz L_spv2
L_spv2_d:
    global_load_lds_dwordx4 v8, s[8:9] offset:0 nt
    global_load_lds_dwordx4 v9, s[8:9] offset:1024 nt
    global_load_lds_dwordx4 v8, s[8:9] offset:2048 nt
    global_load_lds_dwordx4 v9, s[8:9] offset:3072 nt
    s_addk_i32 m0, 4096
    v_xor_b32 v8, 12288, v8
    v_xor_b32 v9, 12288, v9
    global_load_lds_dwordx4 v8, s[8:9] offset:0 nt
    global_load_lds_dwordx4 v9, s[8:9] offset:1024 nt
    global_load_lds_dwordx4 v8, s[8:9] offset:2048 nt
    global_load_lds_dwordx4 v9, s[8:9] offset:3072 nt
    s_addk_i32 m0, 4096
    v_xor_b32 v8, 4096, v8
    v_xor_b32 v9, 4096, v9
    global_load_lds_dwordx4 v8, s[8:9] offset:0 nt
    global_load_lds_dwordx4 v9, s[8:9] offset:1024 nt
    global_load_lds_dwordx4 v8, s[8:9] offset:2048 nt
    global_load_lds_dwordx4 v9, s[8:9] offset:3072 nt
    s_setprio 0
L_b2:
    s_barrier
    ds_read_b128 v[32:35], v51 offset:0
    ds_read_b128 v[36:39], v51 offset:64
    ds_read_b128 v[40:43], v51 offset:128
    ds_read_b128 v[44:47], v51 offset:192
    s_waitcnt lgkmcnt(3)
    v_mfma_f32_16x16x32_bf16 v[56:59], v[16:19], v[32:35], 0
    s_waitcnt lgkmcnt(2)
    v_mfma_f32_16x16x32_bf16 v[56:59], v[20:23], v[36:39], v[56:59]
    s_waitcnt lgkmcnt(1)
    v_mfma_f32_16x16x32_bf16 v[56:59], v[24:27], v[40:43], v[56:59]
    s_waitcnt lgkmcnt(0)
    v_mfma_f32_16x16x32_bf16 v[56:59], v[28:31], v[44:47], v[56:59]
    s_mov_b64 exec, s[46:47]
    s_nop 6
    v_cvt_pk_bf16_f32 v68, v56, v57
    v_cvt_pk_bf16_f32 v69, v58, v59
    v_lshlrev_b32 v56, 16, v68
    v_and_b32 v57, 0xffff0000, v68
    v_lshlrev_b32 v58, 16, v69
    v_and_b32 v59, 0xffff0000, v69
    v_pk_mul_f32 v[56:57], v[56:57], s[44:45] op_sel_hi:[1,0]
    v_pk_mul_f32 v[58:59], v[58:59], s[44:45] op_sel_hi:[1,0]
    v_cvt_pk_bf16_f32 v68, v56, v57
    v_cvt_pk_bf16_f32 v69, v58, v59
    v_lshlrev_b32 v56, 16, v68
    v_and_b32 v57, 0xffff0000, v68
    v_lshlrev_b32 v58, 16, v69
    v_and_b32 v59, 0xffff0000, v69
    ds_write_b128 v53, v[56:59]
    v_max3_f32 v24, v56, v57, v58
    v_max_f32 v24, v24, v59
    ds_max_f32 v14, v24
    s_mov_b64 exec, -1
    s_waitcnt lgkmcnt(0)
    s_barrier
    ds_read_b32 v24, v14
    ds_read_b128 v[16:19], v54
    ds_read_b128 v[20:23], v54 offset:256
    s_waitcnt lgkmcnt(2)
    v_mul_f32 v24, s45, v24
    s_waitcnt lgkmcnt(1)
    v_pk_fma_f32 v[16:17], v[16:17], s[44:45], v[24:25] op_sel:[0,1,0] op_sel_hi:[1,1,0] neg_lo:[0,0,1] neg_hi:[0,0,1]
    v_pk_fma_f32 v[18:19], v[18:19], s[44:45], v[24:25] op_sel:[0,1,0] op_sel_hi:[1,1,0] neg_lo:[0,0,1] neg_hi:[0,0,1]
    s_waitcnt lgkmcnt(0)
    v_pk_fma_f32 v[20:21], v[20:21], s[44:45], v[24:25] op_sel:[0,1,0] op_sel_hi:[1,1,0] neg_lo:[0,0,1] neg_hi:[0,0,1]
    v_pk_fma_f32 v[22:23], v[22:23], s[44:45], v[24:25] op_sel:[0,1,0] op_sel_hi:[1,1,0] neg_lo:[0,0,1] neg_hi:[0,0,1]
    v_exp_f32 v16, v16
    v_exp_f32 v17, v17
    v_exp_f32 v18, v18
    v_exp_f32 v19, v19
    v_exp_f32 v20, v20
    v_exp_f32 v21, v21
    v_exp_f32 v22, v22
    v_exp_f32 v23, v23
    v_cvt_pk_bf16_f32 v32, v16, v17
    v_cvt_pk_bf16_f32 v33, v18, v19
    v_cvt_pk_bf16_f32 v34, v20, v21
    v_cvt_pk_bf16_f32 v35, v22, v23
    v_pk_add_f32 v[26:27], v[16:17], v[18:19]
    v_pk_add_f32 v[28:29], v[20:21], v[22:23]
    v_pk_add_f32 v[26:27], v[26:27], v[28:29]
    v_add_f32 v26, v26, v27
    s_nop 1
    v_add_f32 v26, v26, v26 row_ror:4
    s_nop 1
    v_add_f32 v26, v26, v26 row_ror:8
    v_mov_b32 v25, v26
    s_nop 1
    v_permlane16_swap_b32 v26, v25
    v_add_f32 v26, v26, v25
    v_mov_b32 v25, v26
    s_nop 1
    v_permlane32_swap_b32 v26, v25
    v_add_f32 v26, v26, v25
    v_rcp_f32 v27, v26
    v_log_f32 v26, v26
    v_mov_b32 v36, v32 row_ror:12
    v_mov_b32 v37, v33 row_ror:12
    v_mov_b32 v38, v34 row_ror:12
    v_mov_b32 v39, v35 row_ror:12
    v_mov_b32 v40, v32 row_ror:8
    v_mov_b32 v41, v33 row_ror:8
    v_mov_b32 v42, v34 row_ror:8
    v_mov_b32 v43, v35 row_ror:8
    v_mov_b32 v44, v32 row_ror:4
    v_mov_b32 v45, v33 row_ror:4
    v_mov_b32 v46, v34 row_ror:4
    v_mov_b32 v47, v35 row_ror:4
    s_waitcnt vmcnt(0)
    s_barrier
    ds_read_b64_tr_b16 v[72:73], v61 offset:0
    ds_read_b64_tr_b16 v[74:75], v61 offset:4096
    ds_read_b64_tr_b16 v[76:77], v61 offset:8192
    ds_read_b64_tr_b16 v[78:79], v61 offset:12288
    ds_read_b64_tr_b16 v[80:81], v61 offset:16384
    ds_read_b64_tr_b16 v[82:83], v61 offset:20480
    ds_read_b64_tr_b16 v[84:85], v61 offset:24576
    ds_read_b64_tr_b16 v[86:87], v61 offset:28672
    s_waitcnt lgkmcnt(6)
    v_mfma_f32_16x16x32_bf16 v[56:59], v[72:75], v[32:35], 0
    s_waitcnt lgkmcnt(4)
    v_mfma_f32_16x16x32_bf16 v[56:59], v[76:79], v[36:39], v[56:59]
    s_waitcnt lgkmcnt(2)
    v_mfma_f32_16x16x32_bf16 v[56:59], v[80:83], v[40:43], v[56:59]
    s_waitcnt lgkmcnt(0)
    v_mfma_f32_16x16x32_bf16 v[56:59], v[84:87], v[44:47], v[56:59]
    s_mov_b64 exec, s[46:47]
    s_nop 6
    v_pk_mul_f32 v[56:57], v[56:57], v[26:27] op_sel:[0,1] op_sel_hi:[1,1]
    v_pk_mul_f32 v[58:59], v[58:59], v[26:27] op_sel:[0,1] op_sel_hi:[1,1]
    v_add_f32 v70, v24, v26
    v_cvt_pk_bf16_f32 v68, v56, v57
    v_cvt_pk_bf16_f32 v69, v58, v59
    global_store_dwordx4 v62, v[68:71], s[28:29]
    s_mov_b64 exec, -1
    s_nop 0
    v_add_u32 v62, 4194304, v62
    v_mov_b32 v51, 107296
    v_mov_b32 v52, 1
    s_cmp_ge_u32 s30, 4
    s_cbranch_scc1 L_oproj
    s_movk_i32 s43, 20000
    s_waitcnt vmcnt(0)
L_pollo:
    global_load_dwordx4 v[16:19], v63, s[28:29] offset:0 sc1
    global_load_dwordx4 v[20:23], v63, s[28:29] offset:1024 sc1
    global_load_dwordx4 v[24:27], v63, s[28:29] offset:2048 sc1
    global_load_dwordx4 v[28:31], v63, s[28:29] offset:3072 sc1
    s_sub_u32 s43, s43, 1
    s_cbranch_scc1 L_pollo_done
    s_waitcnt vmcnt(0)
    v_xor_b32 v19, s33, v19
    v_xor_b32 v23, s33, v23
    v_xor_b32 v27, s33, v27
    v_xor_b32 v31, s33, v31
    v_or3_b32 v19, v19, v23, v27
    v_or_b32 v19, v19, v31
    v_cmp_ne_u32 vcc, 0, v19
    s_cbranch_vccz L_pollo_done
    s_cmp_lg_u32 s43, 19976
    s_cbranch_scc1 L_pollo
    v_add_u32 v63, 4194304, v63
    s_mov_b64 exec, s[46:47]
    global_store_dwordx4 v62, v[68:71], s[28:29] sc1
    s_mov_b64 exec, -1
    s_branch L_pollo
L_pollo_done:
    s_waitcnt vmcnt(0)
    s_mov_b64 exec, 1
    ds_add_u32 v51, v52 offset:24
    s_mov_b64 exec, -1
    s_movk_i32 s43, 200
    v_mov_b32 v54, 107296
    v_max3_f32 v32, v18, v22, v26
    v_max_f32 v32, v32, v30
    v_mov_b32 v33, v32
    s_nop 1
    v_permlane32_swap_b32 v32, v33
    v_max_f32 v32, v32, v33
    v_sub_f32 v18, v18, v32
    v_sub_f32 v22, v22, v32
    v_sub_f32 v26, v26, v32
    v_sub_f32 v30, v30, v32
    v_exp_f32 v18, v18
    v_exp_f32 v22, v22
    v_exp_f32 v26, v26
    v_exp_f32 v30, v30
    v_lshlrev_b32 v36, 16, v16
    v_and_b32 v37, 0xffff0000, v16
    v_lshlrev_b32 v38, 16, v17
    v_and_b32 v39, 0xffff0000, v17
    v_lshlrev_b32 v40, 16, v20
    v_and_b32 v41, 0xffff0000, v20
    v_lshlrev_b32 v42, 16, v21
    v_and_b32 v43, 0xffff0000, v21
    v_lshlrev_b32 v44, 16, v24
    v_and_b32 v45, 0xffff0000, v24
    v_lshlrev_b32 v46, 16, v25
    v_and_b32 v47, 0xffff0000, v25
    v_lshlrev_b32 v48, 16, v28
    v_and_b32 v49, 0xffff0000, v28
    v_lshlrev_b32 v50, 16, v29
    v_and_b32 v51, 0xffff0000, v29
    v_add_f32 v32, v18, v22
    v_add_f32 v33, v26, v30
    v_pk_mul_f32 v[36:37], v[36:37], v[18:19] op_sel_hi:[1,0]
    v_pk_mul_f32 v[38:39], v[38:39], v[18:19] op_sel_hi:[1,0]
    v_add_f32 v32, v32, v33
    v_pk_fma_f32 v[36:37], v[40:41], v[22:23], v[36:37] op_sel_hi:[1,0,1]
    v_pk_fma_f32 v[38:39], v[42:43], v[22:23], v[38:39] op_sel_hi:[1,0,1]
    v_pk_fma_f32 v[36:37], v[44:45], v[26:27], v[36:37] op_sel_hi:[1,0,1]
    v_pk_fma_f32 v[38:39], v[46:47], v[26:27], v[38:39] op_sel_hi:[1,0,1]
    v_pk_fma_f32 v[36:37], v[48:49], v[30:31], v[36:37] op_sel_hi:[1,0,1]
    v_pk_fma_f32 v[38:39], v[50:51], v[30:31], v[38:39] op_sel_hi:[1,0,1]
    v_mov_b32 v33, v32
    s_nop 1
    v_permlane32_swap_b32 v32, v33
    v_add_f32 v32, v32, v33
    v_rcp_f32 v32, v32
    v_permlane32_swap_b32 v36, v38
    v_permlane32_swap_b32 v37, v39
    v_pk_add_f32 v[36:37], v[36:37], v[38:39]
    v_pk_mul_f32 v[36:37], v[36:37], v[32:33] op_sel_hi:[1,0]
    v_cvt_pk_bf16_f32 v36, v36, v37
    ds_write_b32 v64, v36
L_spc:
    ds_read_b32 v53, v54 offset:24
    s_waitcnt lgkmcnt(0)
    v_cmp_gt_u32 vcc, 4, v53
    s_cbranch_vccz L_spc_d
    s_sub_u32 s43, s43, 1
    s_cbranch_scc0 L_spc
    s_mov_b64 exec, s[46:47]
    global_store_dwordx4 v62, v[68:71], s[28:29] sc1
    s_mov_b64 exec, -1
L_spc_d:
    s_barrier
    v_mov_b32 v46, 107296
    s_movk_i32 s43, 20000
L_spb:
    ds_read_b32 v47, v46 offset:28
    s_sub_u32 s43, s43, 1
    s_cbranch_scc1 L_spb_d
    s_waitcnt lgkmcnt(0)
    v_cmp_gt_u32 vcc, 4, v47
    s_cbranch_vccnz L_spb
L_spb_d:
    s_mov_b64 exec, s[46:47]
    global_store_dwordx4 v62, v[68:71], s[28:29] sc1
    s_mov_b64 exec, -1
    s_branch L_fin
L_oproj:
    v_mov_b32 v46, 107296
    s_movk_i32 s43, 20000
L_spw:
    ds_read_b32 v47, v46 offset:16
    s_sub_u32 s43, s43, 1
    s_cbranch_scc1 L_spw_d
    s_waitcnt lgkmcnt(0)
    v_cmp_gt_u32 vcc, 1, v47
    s_cbranch_vccnz L_spw
L_spw_d:
    ds_read_b64_tr_b16 v[72:73], v65 offset:0
    ds_read_b64_tr_b16 v[74:75], v65 offset:512
    ds_read_b64_tr_b16 v[76:77], v65 offset:4096
    ds_read_b64_tr_b16 v[78:79], v65 offset:4608
    ds_read_b64_tr_b16 v[80:81], v65 offset:8192
    ds_read_b64_tr_b16 v[82:83], v65 offset:8704
    ds_read_b64_tr_b16 v[84:85], v65 offset:12288
    ds_read_b64_tr_b16 v[86:87], v65 offset:12800
    v_mov_b32 v94, s33
    v_mov_b32 v95, s33
    s_movk_i32 s43, 200
L_spo:
    ds_read_b32 v47, v46 offset:24
    s_waitcnt lgkmcnt(0)
    v_cmp_gt_u32 vcc, 4, v47
    s_cbranch_vccz L_spo_d
    s_sub_u32 s43, s43, 1
    s_cbranch_scc0 L_spo
    s_mov_b64 exec, s[46:47]
    global_store_dwordx4 v62, v[68:71], s[28:29] sc1
    s_mov_b64 exec, -1
L_spo_d:
    s_cmp_eq_u32 s35, s31
    s_setprio 2
    s_waitcnt lgkmcnt(0)
    s_barrier
    ds_read_b128 v[16:19], v66 offset:0
    ds_read_b128 v[20:23], v66 offset:64
    ds_read_b128 v[24:27], v66 offset:128
    ds_read_b128 v[28:31], v66 offset:192
    s_waitcnt lgkmcnt(3)
    v_mfma_f32_16x16x32_bf16 v[56:59], v[72:75], v[16:19], 0
    s_waitcnt lgkmcnt(2)
    v_mfma_f32_16x16x32_bf16 v[56:59], v[76:79], v[20:23], v[56:59]
    s_waitcnt lgkmcnt(1)
    v_mfma_f32_16x16x32_bf16 v[56:59], v[80:83], v[24:27], v[56:59]
    s_waitcnt lgkmcnt(0)
    v_mfma_f32_16x16x32_bf16 v[56:59], v[84:87], v[28:31], v[56:59]
    s_mov_b64 exec, s[48:49]
    s_nop 6
    v_cndmask_b32 v92, v58, v56, s[46:47]
    v_cndmask_b32 v93, v59, v57, s[46:47]
    s_cbranch_scc1 L_sl
    global_store_dwordx4 v67, v[92:95], s[28:29] sc1
    s_branch L_sb
L_sl:
    global_store_dwordx4 v67, v[92:95], s[28:29]
L_sb:
    s_nop 1
    v_add_u32 v67, 4194304, v67
    s_mov_b64 exec, 1
    ds_add_u32 v51, v52 offset:28
    s_mov_b64 exec, -1
    s_mov_b64 exec, s[48:49]
    global_store_dwordx4 v67, v[92:95], s[28:29] sc1
    s_mov_b64 exec, s[46:47]
    global_store_dwordx4 v62, v[68:71], s[28:29] sc1
    s_mov_b64 exec, -1
L_fin:
L_end:
    s_endpgm
L_w8:
    s_setprio 3
    s_and_b32 s31, s2, 7
    s_mov_b32 s58, s31
    v_lshrrev_b32 v2, 4, v0
    v_and_b32 v50, 3, v0
    s_lshr_b32 s32, s2, 3
    s_lshl_b32 s59, s31, 5
    s_add_u32 s59, s59, s32
    s_lshl_b32 s37, s59, 2
    v_lshl_add_u32 v7, v50, 10, s37
    v_bfe_u32 v6, v0, 2, 2
    s_lshl_b32 s37, s34, 8
    s_add_u32 s37, s37, 98304
    v_mul_u32_u24 v11, 1088, v6
    v_lshl_add_u32 v11, v2, 4, v11
    v_add_u32 v11, s37, v11
    v_lshrrev_b32 v12, 2, v0
    v_lshl_add_u32 v12, v2, 2, v12
    v_lshlrev_b32 v12, 7, v12
    v_bfe_u32 v13, v0, 3, 2
    v_lshl_add_u32 v12, v13, 5, v12
    v_lshl_add_u32 v12, v50, 3, v12
    v_xor_b32 v3, 32, v12
    v_xor_b32 v4, 64, v12
    v_xor_b32 v5, 96, v12
    s_lshl_b32 s36, s58, 15
    s_lshl_b32 s37, s32, 8
    s_add_u32 s37, s36, s37
    s_add_u32 s37, s37, 1572864
    v_lshlrev_b32 v13, 13, v6
    v_lshl_add_u32 v14, v2, 2, v50
    v_lshl_add_u32 v13, v14, 4, v13
    v_add_u32 v13, s37, v13
    s_lshl_b32 s36, s31, 15
    s_lshl_b32 s37, s34, 13
    s_add_u32 s37, s36, s37
    s_add_u32 s37, s37, 1576960
    v_lshl_add_u32 v14, v0, 4, s37
    v_lshrrev_b32 v15, 5, v0
    v_lshlrev_b32 v15, 6, v15
    v_lshl_add_u32 v15, v2, 7, v15
    v_lshl_add_u32 v15, v50, 5, v15
    v_lshl_add_u32 v15, v6, 3, v15
    v_add_u32 v15, 102656, v15
    s_mov_b32 s46, 0x11111111
    s_mov_b32 s47, 0x11111111
    s_lshl_b64 s[48:49], s[46:47], 1
    s_lshl_b64 s[50:51], s[46:47], 2
    s_lshl_b64 s[52:53], s[46:47], 3
    s_waitcnt lgkmcnt(0)
    s_mul_i32 s33, s33, 1664525
    s_add_u32 s33, s33, 1013904223
    v_bfe_u32 v60, s33, 0, 5
    v_bfe_u32 v61, s33, 5, 5
    v_bfe_u32 v62, s33, 10, 5
    v_bfe_u32 v63, s33, 15, 5
    s_movk_i32 s44, 31
    v_mov_b32 v54, 107296
    v_mov_b32 v55, 1
    v_mov_b32 v46, 107296
    s_movk_i32 s43, 20000
L_sp8:
    ds_read_b32 v47, v46 offset:0
    s_sub_u32 s43, s43, 1
    s_cbranch_scc1 L_sp8_d
    s_waitcnt lgkmcnt(0)
    v_cmp_gt_u32 vcc, 8, v47
    s_cbranch_vccnz L_sp8
L_sp8_d:
    ds_read_b128 v[16:19], v11 offset:0
    ds_read_b128 v[20:23], v11 offset:64
    ds_read_b128 v[24:27], v11 offset:128
    ds_read_b128 v[28:31], v11 offset:192
    ds_read_b64_tr_b16 v[64:65], v12 offset:0
    ds_read_b64_tr_b16 v[66:67], v12 offset:512
    ds_read_b64_tr_b16 v[68:69], v12 offset:4096
    ds_read_b64_tr_b16 v[70:71], v12 offset:4608
    ds_read_b64_tr_b16 v[72:73], v12 offset:8192
    ds_read_b64_tr_b16 v[74:75], v12 offset:8704
    ds_read_b64_tr_b16 v[76:77], v12 offset:12288
    ds_read_b64_tr_b16 v[78:79], v12 offset:12800
    ds_read_b64_tr_b16 v[80:81], v3 offset:0
    ds_read_b64_tr_b16 v[82:83], v3 offset:512
    ds_read_b64_tr_b16 v[84:85], v3 offset:4096
    ds_read_b64_tr_b16 v[86:87], v3 offset:4608
    ds_read_b64_tr_b16 v[88:89], v3 offset:8192
    ds_read_b64_tr_b16 v[90:91], v3 offset:8704
    ds_read_b64_tr_b16 v[92:93], v3 offset:12288
    ds_read_b64_tr_b16 v[94:95], v3 offset:12800
    s_waitcnt lgkmcnt(8)
    v_mfma_f32_16x16x32_bf16 v[32:35], v[64:67], v[16:19], 0
    v_mfma_f32_16x16x32_bf16 v[32:35], v[68:71], v[20:23], v[32:35]
    v_mfma_f32_16x16x32_bf16 v[32:35], v[72:75], v[24:27], v[32:35]
    v_mfma_f32_16x16x32_bf16 v[32:35], v[76:79], v[28:31], v[32:35]
    ds_read_b64_tr_b16 v[96:97], v4 offset:0
    ds_read_b64_tr_b16 v[98:99], v4 offset:512
    ds_read_b64_tr_b16 v[100:101], v4 offset:4096
    ds_read_b64_tr_b16 v[102:103], v4 offset:4608
    ds_read_b64_tr_b16 v[104:105], v4 offset:8192
    ds_read_b64_tr_b16 v[106:107], v4 offset:8704
    ds_read_b64_tr_b16 v[108:109], v4 offset:12288
    ds_read_b64_tr_b16 v[110:111], v4 offset:12800
    s_mov_b64 exec, s[46:47]
    v_add_u32 v48, 16, v32
    v_add_u32 v49, 16, v33
    v_add_u32 v52, 16, v34
    v_add_u32 v53, 16, v35
    s_mov_b64 exec, -1
    s_waitcnt lgkmcnt(8)
    v_mfma_f32_16x16x32_bf16 v[36:39], v[80:83], v[16:19], 0
    v_mfma_f32_16x16x32_bf16 v[36:39], v[84:87], v[20:23], v[36:39]
    v_mfma_f32_16x16x32_bf16 v[36:39], v[88:91], v[24:27], v[36:39]
    v_mfma_f32_16x16x32_bf16 v[36:39], v[92:95], v[28:31], v[36:39]
    ds_read_b64_tr_b16 v[112:113], v5 offset:0
    ds_read_b64_tr_b16 v[114:115], v5 offset:512
    ds_read_b64_tr_b16 v[116:117], v5 offset:4096
    ds_read_b64_tr_b16 v[118:119], v5 offset:4608
    ds_read_b64_tr_b16 v[120:121], v5 offset:8192
    ds_read_b64_tr_b16 v[122:123], v5 offset:8704
    ds_read_b64_tr_b16 v[124:125], v5 offset:12288
    ds_read_b64_tr_b16 v[126:127], v5 offset:12800
    s_mov_b64 exec, s[48:49]
    v_add_u32 v48, 16, v36
    v_add_u32 v49, 16, v37
    v_add_u32 v52, 16, v38
    v_add_u32 v53, 16, v39
    s_mov_b64 exec, -1
    s_waitcnt lgkmcnt(8)
    v_mfma_f32_16x16x32_bf16 v[40:43], v[96:99], v[16:19], 0
    v_mfma_f32_16x16x32_bf16 v[40:43], v[100:103], v[20:23], v[40:43]
    v_mfma_f32_16x16x32_bf16 v[40:43], v[104:107], v[24:27], v[40:43]
    v_mfma_f32_16x16x32_bf16 v[40:43], v[108:111], v[28:31], v[40:43]
    s_waitcnt lgkmcnt(6)
    v_mfma_f32_16x16x32_bf16 v[44:47], v[112:115], v[16:19], 0
    s_waitcnt lgkmcnt(4)
    v_mfma_f32_16x16x32_bf16 v[44:47], v[116:119], v[20:23], v[44:47]
    s_waitcnt lgkmcnt(2)
    v_mfma_f32_16x16x32_bf16 v[44:47], v[120:123], v[24:27], v[44:47]
    s_waitcnt lgkmcnt(0)
    v_mfma_f32_16x16x32_bf16 v[44:47], v[124:127], v[28:31], v[44:47]
    s_mov_b64 exec, s[50:51]
    v_add_u32 v48, 16, v40
    v_add_u32 v49, 16, v41
    v_add_u32 v52, 16, v42
    v_add_u32 v53, 16, v43
    s_mov_b64 exec, s[52:53]
    s_nop 1
    v_add_u32 v48, 16, v44
    v_add_u32 v49, 16, v45
    v_add_u32 v52, 16, v46
    v_add_u32 v53, 16, v47
    s_mov_b64 exec, -1
    v_bfi_b32 v68, s44, v60, v48
    v_bfi_b32 v69, s44, v61, v49
    v_bfi_b32 v70, s44, v62, v52
    v_bfi_b32 v71, s44, v63, v53
    global_store_dwordx4 v13, v[68:71], s[28:29]
    ds_write_b32 v54, v55 offset:12
    global_load_dword v9, v7, s[4:5]
    s_load_dword s38, s[22:23], 0
    v_add_u32 v13, 4194304, v13
    v_or_b32 v4, 64, v0
    v_lshlrev_b32 v4, 7, v4
    v_min_u32 v4, L_cend-L_pc, v4
    global_load_dword v58, v4, s[56:57]
    s_bfe_u32 s35, s2, 0x30003
    s_mov_b32 s61, s35
    s_lshl2_add_u32 s39, s31, s34
    s_lshl_b32 s40, s39, 17
    s_lshl_b32 s41, s61, 7
    s_add_u32 s40, s40, s41
    s_mov_b32 s36, s34
    s_lshl_b32 s41, s36, 15
    s_add_u32 s40, s40, s41
    v_lshrrev_b32 v64, 3, v0
    v_lshlrev_b32 v64, 10, v64
    v_and_b32 v65, 7, v0
    v_lshl_add_u32 v64, v65, 4, v64
    v_add_u32 v64, s40, v64
    v_add_u32 v65, 7168, v64
    v_add_u32 v66, 14336, v64
    v_add_u32 v67, 21504, v64
    s_lshl_b32 s41, s36, 12
    s_add_u32 m0, s41, 81920
    v_mov_b32 v46, 107296
    s_movk_i32 s43, 20000
L_spt:
    ds_read_b32 v47, v46 offset:20
    s_sub_u32 s43, s43, 1
    s_cbranch_scc1 L_spt_d
    s_waitcnt lgkmcnt(0)
    v_cmp_gt_u32 vcc, 1, v47
    s_cbranch_vccnz L_spt
L_spt_d:
    s_movk_i32 s43, 20000
L_pollq:
    global_load_dwordx4 v[16:19], v14, s[28:29] offset:-4096 sc1
    global_load_dwordx4 v[20:23], v14, s[28:29] offset:-3072 sc1
    global_load_dwordx4 v[24:27], v14, s[28:29] offset:-2048 sc1
    global_load_dwordx4 v[28:31], v14, s[28:29] offset:-1024 sc1
    global_load_dwordx4 v[32:35], v14, s[28:29] offset:0 sc1
    global_load_dwordx4 v[36:39], v14, s[28:29] offset:1024 sc1
    global_load_dwordx4 v[40:43], v14, s[28:29] offset:2048 sc1
    global_load_dwordx4 v[44:47], v14, s[28:29] offset:3072 sc1
    ds_write_b32 v54, v55 offset:8
    v_mov_b32 v55, 2
    s_sub_u32 s43, s43, 1
    s_cbranch_scc1 L_pollq_done
    s_waitcnt vmcnt(7)
    v_xor_b32 v16, v60, v16
    v_xor_b32 v17, v61, v17
    v_xor_b32 v18, v62, v18
    v_xor_b32 v19, v63, v19
    v_or_b32 v57, v16, v17
    v_or3_b32 v57, v57, v18, v19
    s_waitcnt vmcnt(6)
    v_xor_b32 v20, v60, v20
    v_xor_b32 v21, v61, v21
    v_xor_b32 v22, v62, v22
    v_xor_b32 v23, v63, v23
    v_or3_b32 v57, v57, v20, v21
    v_or3_b32 v57, v57, v22, v23
    s_waitcnt vmcnt(5)
    v_xor_b32 v24, v60, v24
    v_xor_b32 v25, v61, v25
    v_xor_b32 v26, v62, v26
    v_xor_b32 v27, v63, v27
    v_or3_b32 v57, v57, v24, v25
    v_or3_b32 v57, v57, v26, v27
    v_pk_add_f32 v[16:17], v[16:17], v[24:25]
    v_pk_add_f32 v[18:19], v[18:19], v[26:27]
    s_waitcnt vmcnt(4)
    v_xor_b32 v28, v60, v28
    v_xor_b32 v29, v61, v29
    v_xor_b32 v30, v62, v30
    v_xor_b32 v31, v63, v31
    v_or3_b32 v57, v57, v28, v29
    v_or3_b32 v57, v57, v30, v31
    v_pk_add_f32 v[20:21], v[20:21], v[28:29]
    v_pk_add_f32 v[22:23], v[22:23], v[30:31]
    s_waitcnt vmcnt(3)
    v_xor_b32 v32, v60, v32
    v_xor_b32 v33, v61, v33
    v_xor_b32 v34, v62, v34
    v_xor_b32 v35, v63, v35
    v_or3_b32 v57, v57, v32, v33
    v_or3_b32 v57, v57, v34, v35
    v_pk_add_f32 v[16:17], v[16:17], v[32:33]
    v_pk_add_f32 v[18:19], v[18:19], v[34:35]
    s_waitcnt vmcnt(2)
    v_xor_b32 v36, v60, v36
    v_xor_b32 v37, v61, v37
    v_xor_b32 v38, v62, v38
    v_xor_b32 v39, v63, v39
    v_or3_b32 v57, v57, v36, v37
    v_or3_b32 v57, v57, v38, v39
    v_pk_add_f32 v[20:21], v[20:21], v[36:37]
    v_pk_add_f32 v[22:23], v[22:23], v[38:39]
    s_waitcnt vmcnt(1)
    v_xor_b32 v40, v60, v40
    v_xor_b32 v41, v61, v41
    v_xor_b32 v42, v62, v42
    v_xor_b32 v43, v63, v43
    v_or3_b32 v57, v57, v40, v41
    v_or3_b32 v57, v57, v42, v43
    v_pk_add_f32 v[16:17], v[16:17], v[40:41]
    v_pk_add_f32 v[18:19], v[18:19], v[42:43]
    s_waitcnt vmcnt(0)
    v_xor_b32 v44, v60, v44
    v_xor_b32 v45, v61, v45
    v_xor_b32 v46, v62, v46
    v_xor_b32 v47, v63, v47
    v_or3_b32 v57, v57, v44, v45
    v_or3_b32 v57, v57, v46, v47
    v_pk_add_f32 v[20:21], v[20:21], v[44:45]
    v_pk_add_f32 v[22:23], v[22:23], v[46:47]
    v_and_b32 v57, s44, v57
    v_cmp_ne_u32 vcc, 0, v57
    s_cbranch_vccz L_pollq_done
    s_cmp_lg_u32 s43, 19976
    s_cbranch_scc1 L_pollq
    v_add_u32 v14, 4194304, v14
    global_store_dwordx4 v13, v[68:71], s[28:29] sc1
    s_branch L_pollq
L_pollq_done:
    s_waitcnt vmcnt(0)
    ds_write_b32 v54, v55 offset:8
    v_cvt_pk_bf16_f32 v16, v16, v17
    v_cvt_pk_bf16_f32 v17, v18, v19
    v_cvt_pk_bf16_f32 v20, v20, v21
    v_cvt_pk_bf16_f32 v21, v22, v23
    ds_write_b64 v15, v[16:17]
    ds_write_b64 v15, v[20:21] offset:640
    s_waitcnt lgkmcnt(0)
    s_barrier
    global_store_dwordx4 v13, v[68:71], s[28:29] sc1
    v_lshlrev_b32 v11, 3, v50
    v_add_u32 v11, 107360, v11
    ds_read_b64 v[16:17], v11 offset:0
    ds_read_b64 v[18:19], v11 offset:32
    ds_read_b64 v[20:21], v11 offset:64
    ds_read_b64 v[22:23], v11 offset:96
    ds_read_b64 v[24:25], v11 offset:128
    ds_read_b64 v[26:27], v11 offset:160
    ds_read_b64 v[28:29], v11 offset:192
    s_barrier
    global_load_lds_dwordx4 v64, s[12:13] offset:0 nt
    global_load_lds_dwordx4 v65, s[12:13] offset:1024 nt
    global_load_lds_dwordx4 v66, s[12:13] offset:2048 nt
    global_load_lds_dwordx4 v67, s[12:13] offset:3072 nt
    s_xor_b32 m0, m0, 4096
    v_xor_b32 v64, 32768, v64
    v_xor_b32 v65, 32768, v65
    v_xor_b32 v66, 32768, v66
    v_xor_b32 v67, 32768, v67
    global_load_lds_dwordx4 v64, s[12:13] offset:0 nt
    global_load_lds_dwordx4 v65, s[12:13] offset:1024 nt
    global_load_lds_dwordx4 v66, s[12:13] offset:2048 nt
    global_load_lds_dwordx4 v67, s[12:13] offset:3072 nt
    s_xor_b32 m0, m0, 12288
    v_xor_b32 v64, 98304, v64
    v_xor_b32 v65, 98304, v65
    v_xor_b32 v66, 98304, v66
    v_xor_b32 v67, 98304, v67
    global_load_lds_dwordx4 v64, s[12:13] offset:0 nt
    global_load_lds_dwordx4 v65, s[12:13] offset:1024 nt
    global_load_lds_dwordx4 v66, s[12:13] offset:2048 nt
    global_load_lds_dwordx4 v67, s[12:13] offset:3072 nt
    s_xor_b32 m0, m0, 4096
    v_xor_b32 v64, 32768, v64
    v_xor_b32 v65, 32768, v65
    v_xor_b32 v66, 32768, v66
    v_xor_b32 v67, 32768, v67
    global_load_lds_dwordx4 v64, s[12:13] offset:0 nt
    global_load_lds_dwordx4 v65, s[12:13] offset:1024 nt
    global_load_lds_dwordx4 v66, s[12:13] offset:2048 nt
    global_load_lds_dwordx4 v67, s[12:13] offset:3072 nt
    s_setprio 0
    s_lshl_b32 s37, s59, 11
    s_add_u32 s37, s37, 1048576
    v_lshl_add_u32 v14, v0, 4, s37
    s_waitcnt lgkmcnt(0)
    s_lshl_b32 s38, s38, 16
    v_pk_add_f32 v[16:17], v[16:17], v[18:19]
    v_pk_add_f32 v[16:17], v[16:17], v[20:21]
    v_pk_add_f32 v[16:17], v[16:17], v[22:23]
    v_pk_add_f32 v[16:17], v[16:17], v[24:25]
    v_pk_add_f32 v[16:17], v[16:17], v[26:27]
    v_pk_add_f32 v[16:17], v[16:17], v[28:29]
    v_cvt_pk_bf16_f32 v18, v16, v17
    v_lshlrev_b32 v16, 16, v18
    v_and_b32 v17, 0xffff0000, v18
    v_add_f32 v16, s38, v16
    v_add_f32 v17, s38, v17
    v_cvt_pk_bf16_f32 v18, v16, v17
    v_lshlrev_b32 v16, 16, v18
    v_and_b32 v17, 0xffff0000, v18
    v_mul_f32 v18, 0xbfb8aa3b, v16
    v_mul_f32 v19, 0xbfb8aa3b, v17
    v_exp_f32 v18, v18
    v_exp_f32 v19, v19
    v_add_f32 v18, 1.0, v18
    v_add_f32 v19, 1.0, v19
    v_rcp_f32 v18, v18
    v_rcp_f32 v19, v19
    v_mul_f32 v16, v16, v18
    v_mul_f32 v17, v17, v19
    v_cvt_pk_bf16_f32 v18, v16, v17
    v_lshlrev_b32 v30, 16, v18
    v_and_b32 v31, 0xffff0000, v18
    v_lshlrev_b32 v8, 16, v9
    v_and_b32 v10, 0xffff0000, v9
    s_barrier
    s_waitcnt vmcnt(0)
    ds_write_b32 v54, v55 offset:16
    s_barrier
    s_setprio 1
    s_movk_i32 s43, 20000
    s_waitcnt vmcnt(0)
L_polls:
    global_load_dwordx4 v[16:19], v14, s[28:29] offset:0 sc1
    global_load_dwordx4 v[20:23], v14, s[28:29] offset:1024 sc1
    s_sub_u32 s43, s43, 1
    s_cbranch_scc1 L_polls_done
    s_waitcnt vmcnt(0)
    v_cmp_ne_u32 vcc, s33, v19
    v_cmp_ne_u32 s[54:55], s33, v23
    s_or_b64 vcc, vcc, s[54:55]
    s_cbranch_vccz L_polls_done
    s_cmp_lg_u32 s43, 19976
    s_cbranch_scc1 L_polls
    v_add_u32 v14, 4194304, v14
    s_branch L_polls
L_polls_done:
    s_waitcnt vmcnt(0)
    v_pk_add_f32 v[16:17], v[16:17], v[20:21]
    s_nop 1
    v_add_f32 v16, v16, v16 row_ror:4
    v_add_f32 v17, v17, v17 row_ror:4
    s_nop 0
    v_add_f32 v16, v16, v16 row_ror:8
    v_add_f32 v17, v17, v17 row_ror:8
    v_mov_b32 v18, v16
    v_mov_b32 v19, v17
    s_nop 0
    v_permlane16_swap_b32 v16, v18
    v_permlane16_swap_b32 v17, v19
    v_add_f32 v16, v16, v18
    v_add_f32 v17, v17, v19
    v_mov_b32 v18, v16
    v_mov_b32 v19, v17
    s_nop 0
    v_permlane32_swap_b32 v16, v18
    v_permlane32_swap_b32 v17, v19
    v_add_f32 v16, v16, v18
    v_add_f32 v17, v17, v19
    v_cvt_pk_bf16_f32 v18, v16, v17
    v_lshlrev_b32 v16, 16, v18
    v_and_b32 v17, 0xffff0000, v18
    v_pk_mul_f32 v[16:17], v[16:17], v[30:31]
    v_cvt_pk_bf16_f32 v18, v16, v17
    v_lshlrev_b32 v16, 16, v18
    v_and_b32 v17, 0xffff0000, v18
    v_add_f32 v16, v16, v8
    v_add_f32 v17, v17, v10
    v_cvt_pk_bf16_f32 v18, v16, v17
    s_mov_b64 exec, 15
    global_store_dword v7, v18, s[24:25]
    s_cmp_lg_u32 s2, 0
    s_cbranch_scc1 L_fin8
    s_mov_b64 exec, 1
    v_mov_b32 v20, 0
    v_mov_b32 v21, s33
    global_store_dword v20, v21, s[28:29]
L_fin8:
L_cend:
    s_endpgm
.section .rodata,"a"
.p2align 6
.amdhsa_kernel recurrent_scan__sliding_block_cached__mixer_token_mlp__decode_kernel
  .amdhsa_next_free_vgpr 128
  .amdhsa_next_free_sgpr 96
  .amdhsa_accum_offset 128
  .amdhsa_group_segment_fixed_size 0
  .amdhsa_kernarg_size 104
  .amdhsa_user_sgpr_count 2
  .amdhsa_user_sgpr_kernarg_segment_ptr 1
  .amdhsa_system_sgpr_workgroup_id_x 1
.end_amdhsa_kernel
```
